```python
import torch

def _softmax(x, axis=-1):
    return torch.softmax(x, dim=axis)
def _gelu(x):
    return torch.nn.functional.gelu(x, approximate="tanh")
def _silu(x):
    return torch.nn.functional.silu(x)
def _sigmoid(x):
    return torch.sigmoid(x)
def _layernorm(x, axis=-1, eps=1e-5):
    m = x.mean(dim=axis, keepdim=True)
    v = x.var(dim=axis, keepdim=True, unbiased=False)
    return (x - m) / torch.sqrt(v + eps)
def _scatter_add(tgt, idx, src, axis=0):
    return tgt.clone().index_add_(axis, idx, src)
def _segment_sum(src, seg, n):
    out = torch.zeros((n,) + src.shape[1:], dtype=src.dtype)
    return out.index_add_(0, seg, src)
def _pad(x, pw):
    flat = tuple(v for pair in reversed(pw) for v in pair)
    return torch.nn.functional.pad(x, flat)

kernel_name = 'gated_mix__sliding_block_cached__sliding_block_cached__decode'

def setup_inputs():

    _w = (lambda a: (lambda t: t.to(torch.bfloat16) if t.is_floating_point() else t)(torch.as_tensor(a)))
    def _A_setup():
        B, Sq, D = 4, 1, 512
        Hq, Hkv, Sk, Dh = 32, 8, 8192, 128
        assert Hq % Hkv == 0, (Hq, Hkv)
        return {
            "x": _w((lambda *s: torch.randn(*s, dtype=torch.bfloat16) * 0.05)(B, Sq, D)),
            "k_cache": _w((lambda *s: torch.randn(*s, dtype=torch.bfloat16) * 6.4)(B, Hkv, Sk, Dh)),
            "v_cache": _w((lambda *s: torch.randn(*s, dtype=torch.bfloat16) * 0.05)(B, Hkv, Sk, Dh)),
            "wq": _w((lambda *s: torch.randn(*s, dtype=torch.bfloat16) * 6.4)(D, Hq * Dh) * (D ** -0.5)),
            "wo": _w((lambda *s: torch.randn(*s, dtype=torch.bfloat16) * 0.05)(Hq * Dh, D) * ((Hq * Dh) ** -0.5)),
        }
    _A_in = _A_setup()

    def _B_setup():
        B, Sq, D = 4, 1, 512
        Hq, Hkv, Sk, Dh = 32, 8, 8192, 128
        assert Hq % Hkv == 0, (Hq, Hkv)
        return {
            "x": _w((lambda *s: torch.randn(*s, dtype=torch.bfloat16) * 0.05)(B, Sq, D)),
            "k_cache": _w((lambda *s: torch.randn(*s, dtype=torch.bfloat16) * 6.4)(B, Hkv, Sk, Dh)),
            "v_cache": _w((lambda *s: torch.randn(*s, dtype=torch.bfloat16) * 0.05)(B, Hkv, Sk, Dh)),
            "wq": _w((lambda *s: torch.randn(*s, dtype=torch.bfloat16) * 6.4)(D, Hq * Dh) * (D ** -0.5)),
            "wo": _w((lambda *s: torch.randn(*s, dtype=torch.bfloat16) * 0.05)(Hq * Dh, D) * ((Hq * Dh) ** -0.5)),
        }
    _B_in = _B_setup()

    return {
        "A_x": _A_in["x"],
        "A_k_cache": _A_in["k_cache"],
        "A_v_cache": _A_in["v_cache"],
        "A_wq": _A_in["wq"],
        "A_wo": _A_in["wo"],
        "B_x": _B_in["x"],
        "B_k_cache": _B_in["k_cache"],
        "B_v_cache": _B_in["v_cache"],
        "B_wq": _B_in["wq"],
        "B_wo": _B_in["wo"],
        "gate_w": _w((lambda *s: torch.randn(*s, dtype=torch.bfloat16) * 0.05)(512) * 16.0),
    }

def reference(A_x, A_k_cache, A_v_cache, A_wq, A_wo, B_x, B_k_cache, B_v_cache, B_wq, B_wo, gate_w):
    def _A_ref(x, k_cache, v_cache, wq, wo):
        B, Sq, D = x.shape
        Hq, Dh = 32, 128
        Hkv, Sk = k_cache.shape[1], k_cache.shape[2]
        W = min(4096, max(256, Sk // 4))
        rep = Hq // Hkv
        q = (lambda x, *d: x.permute(*d))((x @ wq).reshape(B, Sq, Hq, Dh), 0, 2, 1, 3)
        k = (lambda x, n, axis: torch.repeat_interleave(x, n, dim=axis))(k_cache[:, :, Sk - W:, :], rep, axis=1)
        v = (lambda x, n, axis: torch.repeat_interleave(x, n, dim=axis))(v_cache[:, :, Sk - W:, :], rep, axis=1)
        scores = torch.einsum("bhqd,bhkd->bhqk", q, k) * (Dh ** -0.5)
        p = _softmax(scores, axis=-1)
        o = torch.einsum("bhqk,bhkd->bhqd", p, v)
        return (lambda x, *d: x.permute(*d))(o, 0, 2, 1, 3).reshape(B, Sq, Hq * Dh) @ wo

    def _B_ref(x, k_cache, v_cache, wq, wo):
        B, Sq, D = x.shape
        Hq, Dh = 32, 128
        Hkv, Sk = k_cache.shape[1], k_cache.shape[2]
        W = min(4096, max(256, Sk // 4))
        rep = Hq // Hkv
        q = (lambda x, *d: x.permute(*d))((x @ wq).reshape(B, Sq, Hq, Dh), 0, 2, 1, 3)
        k = (lambda x, n, axis: torch.repeat_interleave(x, n, dim=axis))(k_cache[:, :, Sk - W:, :], rep, axis=1)
        v = (lambda x, n, axis: torch.repeat_interleave(x, n, dim=axis))(v_cache[:, :, Sk - W:, :], rep, axis=1)
        scores = torch.einsum("bhqd,bhkd->bhqk", q, k) * (Dh ** -0.5)
        p = _softmax(scores, axis=-1)
        o = torch.einsum("bhqk,bhkd->bhqd", p, v)
        return (lambda x, *d: x.permute(*d))(o, 0, 2, 1, 3).reshape(B, Sq, Hq * Dh) @ wo

    x = A_x
    g = _sigmoid((x * gate_w).sum(-1, keepdims=True))
    a = _A_ref(x, A_k_cache, A_v_cache, A_wq, A_wo)
    b = _B_ref(x, B_k_cache, B_v_cache, B_wq, B_wo)
    return g * a + (1 - g) * b
```

```asm
; @launch grid=(256,1,1) block=(512,1,1) lds=146688
.amdgcn_target "amdgcn-amd-amdhsa--gfx950"
.text
.globl gated_mix__sliding_block_cached__sliding_block_cached__decode_kernel
.p2align 8
.type gated_mix__sliding_block_cached__sliding_block_cached__decode_kernel,@function
gated_mix__sliding_block_cached__sliding_block_cached__decode_kernel:
  s_cmpk_ge_u32 s2, 0x100
  s_cbranch_scc1 L_end
  s_and_b32 s52, s2, 8
  s_mul_i32 s52, s52, 5
  s_load_dwordx8 s[32:39], s[0:1], s52 offset:8
  s_load_dwordx2 s[40:41], s[0:1], 0
  s_load_dwordx8 s[44:51], s[0:1], 80
  v_lshrrev_b32 v1, 6, v0
  v_and_b32 v0, 63, v0
  v_readfirstlane_b32 s6, v1
  v_lshlrev_b32 v14, 4, v0
  s_bitcmp1_b32 s6, 2
  s_cbranch_scc1 L_vwave
  s_lshr_b32 s58, s2, 6
  s_and_b32 s4, s2, 7
  s_lshl3_add_u32 s54, s58, s4
  s_lshr_b32 s5, s2, 4
  s_and_b32 s59, s5, 3
  s_lshl2_add_u32 s54, s54, 3
  s_lshl_b32 s54, s54, 7
  s_lshl2_add_u32 s59, s59, s6
  s_add_u32 s54, s54, s59
  s_lshl_b32 s54, s54, 12
  s_lshl_b32 s96, s2, 29
  s_lshl_b32 s97, 1, 29
  s_lshl_b32 s10, 1, 26
  s_mov_b32 s11, 0x20000
  s_lshr_b32 s59, s5, 1
  s_cmp_eq_u32 s59, 3
  s_cselect_b32 s98, 1, 0
  v_and_b32 v3, 48, v0
  v_lshlrev_b32 v3, 2, v3
  v_xor_b32 v10, v14, v3
  v_add_u32 v10, s54, v10
  v_xor_b32 v11, 16, v10
  v_xor_b32 v12, 32, v10
  v_xor_b32 v13, 48, v10
  s_lshl_b32 m0, s6, 15
  s_mov_b32 s59, 7
  s_setprio 1
  s_waitcnt lgkmcnt(0)
  s_mov_b64 s[8:9], s[32:33]
  s_barrier
  s_cmp_eq_u32 s98, 1
  s_cbranch_scc1 L_kloop1
L_kloop0:
  s_lshr_b32 s56, s96, 13
  s_waitcnt vmcnt(4)
  buffer_load_dwordx4 v10, s[8:11], s56 offen offset:0 nt lds
  s_waitcnt vmcnt(4)
  buffer_load_dwordx4 v11, s[8:11], s56 offen offset:1024 nt lds
  s_waitcnt vmcnt(4)
  buffer_load_dwordx4 v12, s[8:11], s56 offen offset:2048 nt lds
  s_waitcnt vmcnt(4)
  buffer_load_dwordx4 v13, s[8:11], s56 offen offset:3072 nt lds
  s_add_u32 s96, s96, s97
  s_addk_i32 m0, 0x1000
  s_sub_u32 s59, s59, 1
  s_cbranch_scc0 L_kloop0
  s_branch L_entry_end
L_kloop1:
  s_lshr_b32 s56, s96, 13
  s_waitcnt vmcnt(11)
  buffer_load_dwordx4 v10, s[8:11], s56 offen offset:0 nt lds
  s_waitcnt vmcnt(11)
  buffer_load_dwordx4 v11, s[8:11], s56 offen offset:1024 nt lds
  s_waitcnt vmcnt(11)
  buffer_load_dwordx4 v12, s[8:11], s56 offen offset:2048 nt lds
  s_waitcnt vmcnt(11)
  buffer_load_dwordx4 v13, s[8:11], s56 offen offset:3072 nt lds
  s_add_u32 s96, s96, s97
  s_addk_i32 m0, 0x1000
  s_sub_u32 s59, s59, 1
  s_cbranch_scc0 L_kloop1
L_entry_end:
  s_barrier
  s_load_dword s7, s[50:51], 0x0
  s_and_b32 s3, s2, 15
  s_and_b32 s59, s5, 3
  s_and_b32 s42, s2, 7
  s_mov_b32 s60, 0x05040100
  s_mov_b32 s61, 0x07060302
  s_mov_b32 s18, 0x400000
  s_mov_b32 s19, 0x20000
  s_mov_b32 s22, 285221888
  s_mov_b32 s23, 0x20000
  s_mov_b32 s26, 4096
  s_mov_b32 s27, 0x20000
  s_lshl_b32 s55, s6, 15
  s_lshl2_add_u32 s63, s59, s58
  s_lshl4_add_u32 s63, s3, s63
  s_getreg_b32 s12, hwreg(HW_REG_XCC_ID, 0, 3)
  v_lshrrev_b32 v1, 4, v0
  v_and_b32 v2, 15, v0
  v_bfe_u32 v5, v0, 2, 2
  v_and_b32 v16, 3, v0
  s_mov_b64 s[20:21], s[50:51]
  s_lshl2_add_u32 s57, s3, s58
  s_lshl2_add_u32 s57, s57, s6
  s_lshl_b32 s57, s57, 10
  s_add_u32 s57, s57, 0x140000
  buffer_load_dwordx4 v[64:67], v14, s[20:23], s57 offen sc1 nt
  s_mov_b32 s24, s46
  s_mov_b32 s25, s47
  s_mov_b32 s16, s38
  s_mov_b32 s17, s39
  v_lshlrev_b32 v15, 10, v1
  v_lshl_add_u32 v15, v2, 4, v15
  v_lshl_add_u32 v4, v16, 2, v5
  v_lshlrev_b32 v4, 8, v4
  v_add_u32 v4, s55, v4
  v_xor_b32 v6, v1, v2
  v_lshlrev_b32 v6, 4, v6
  v_xor_b32 v7, 0, v6
  v_add_u32 v20, v4, v7
  v_xor_b32 v7, 64, v6
  v_add_u32 v21, v4, v7
  v_xor_b32 v7, 128, v6
  v_add_u32 v22, v4, v7
  v_xor_b32 v7, 192, v6
  v_add_u32 v23, v4, v7
  v_lshlrev_b32 v7, 8, v16
  v_lshl_add_u32 v7, v1, 4, v7
  v_add_u32 v7, 131072, v7
  v_mov_b32 v8, 132096
  v_cmp_eq_u32 vcc, 0, v5
  s_nop 1
  v_cndmask_b32 v32, v8, v7, vcc
  v_cmp_eq_u32 vcc, 1, v5
  s_nop 1
  v_cndmask_b32 v33, v8, v7, vcc
  v_cmp_eq_u32 vcc, 2, v5
  s_nop 1
  v_cndmask_b32 v34, v8, v7, vcc
  v_cmp_eq_u32 vcc, 3, v5
  s_nop 1
  v_cndmask_b32 v35, v8, v7, vcc
  s_lshl_b32 s59, s6, 8
  s_add_u32 s59, s59, 131072
  v_lshrrev_b32 v9, 5, v0
  v_lshlrev_b32 v9, 7, v9
  v_bfe_u32 v8, v0, 3, 1
  v_lshl_add_u32 v9, v8, 6, v9
  v_and_b32 v8, 7, v0
  v_lshl_add_u32 v9, v8, 1, v9
  v_add_u32 v9, s59, v9
  v_lshlrev_b32 v18, 4, v16
  s_lshl_b32 s59, s6, 2
  s_add_u32 s59, s59, 137216
  v_add_u32 v18, s59, v18
  v_lshl_add_u32 v17, v1, 2, v16
  v_lshlrev_b32 v17, 4, v17
  v_lshrrev_b32 v8, 1, v5
  v_lshl_add_u32 v17, v8, 8, v17
  v_and_b32 v8, 1, v5
  v_lshl_add_u32 v17, v8, 3, v17
  s_lshl_b32 s59, s6, 10
  s_add_u32 s59, s59, 133120
  v_add_u32 v17, s59, v17
  s_waitcnt lgkmcnt(0)
  s_add_u32 s7, s7, 0x9e3779b1
  s_mov_b32 s59, 200000
  s_add_u32 s62, s7, s12
L_pollq:
  s_waitcnt vmcnt(0)
  v_subrev_u32 v6, s7, v67
  v_cmp_lt_u32 vcc, 7, v6
  s_cbranch_vccz L_gotq
  s_sub_u32 s59, s59, 1
  s_cbranch_scc1 L_gotq
  buffer_load_dwordx4 v[64:67], v14, s[20:23], s57 offen sc1
  s_branch L_pollq
L_gotq:
  v_cmp_ne_u32 vcc, s62, v67
  s_mov_b32 s56, 0x04000c0c
  s_mov_b32 s57, 0x0706000c
  v_perm_b32 v27, v64, v65, s56
  v_perm_b32 v27, v27, v66, s57
  s_cmp_eq_u64 vcc, 0
  s_cselect_b32 s59, 1, 0x101
  v_mov_b32 v24, v64
  v_mov_b32 v25, v65
  v_mov_b32 v26, v66
  v_mov_b32 v28, v24
  v_mov_b32 v29, v25
  v_mov_b32 v30, v26
  v_mov_b32 v31, v27
  s_nop 0
  v_permlane16_swap_b32 v24, v28
  v_permlane16_swap_b32 v25, v29
  v_permlane16_swap_b32 v26, v30
  v_permlane16_swap_b32 v27, v31
  s_nop 0
  v_add_f32 v24, v24, v28
  v_add_f32 v25, v25, v29
  v_add_f32 v26, v26, v30
  v_add_f32 v27, v27, v31
  v_cvt_pk_bf16_f32 v24, v24, v25
  v_cvt_pk_bf16_f32 v25, v26, v27
  v_mov_b32 v6, 137348
  v_mov_b32 v7, s59
  ds_write_b16 v9, v24
  ds_write_b16_d16_hi v9, v24 offset:16
  ds_write_b16 v9, v25 offset:32
  ds_write_b16_d16_hi v9, v25 offset:48
  s_mov_b64 exec, 1
  ds_add_u32 v6, v7
  s_mov_b64 exec, -1
  ds_read_b128 v[96:99], v20 offset:0
  ds_read_b128 v[100:103], v21 offset:0
  ds_read_b128 v[104:107], v22 offset:0
  ds_read_b128 v[108:111], v23 offset:0
  ds_read_b128 v[112:115], v20 offset:16384
  ds_read_b128 v[116:119], v21 offset:16384
  ds_read_b128 v[120:123], v22 offset:16384
  ds_read_b128 v[124:127], v23 offset:16384
  s_mov_b32 s59, 200000
  s_mov_b32 s62, 0x3db504f3
  s_mov_b32 s14, 0x3fb8aa3b
L_qspin:
  ds_read_b32 v7, v6
  s_waitcnt lgkmcnt(0)
  v_readfirstlane_b32 s13, v7
  s_and_b32 s56, s13, 255
  s_cmp_eq_u32 s56, 4
  s_cbranch_scc1 L_qall
  s_sub_u32 s59, s59, 1
  s_cbranch_scc0 L_qspin
L_qall:
  ds_read_b128 v[64:67], v32 offset:0
  ds_read_b128 v[68:71], v32 offset:64
  ds_read_b128 v[72:75], v32 offset:128
  ds_read_b128 v[76:79], v32 offset:192
  s_lshr_b32 s13, s13, 8
  s_cbranch_scc0 L_norep
  s_lshl2_add_u32 s57, s3, s6
  s_lshl4_add_u32 s57, s57, s5
  s_lshl_b32 s57, s57, 8
  s_add_u32 s57, s57, 0x140000
  s_add_u32 s56, s7, s12
  s_mov_b32 s59, 200000
  s_mov_b64 exec, 0xffff
L_rep:
  buffer_load_dwordx4 v[24:27], v14, s[20:23], s57 offen sc1
  s_waitcnt vmcnt(0)
  v_cmp_ne_u32 vcc, s56, v27
  s_cbranch_vccz L_rep2
  s_sub_u32 s59, s59, 1
  s_cbranch_scc0 L_rep
L_rep2:
  buffer_store_dwordx4 v[24:27], v14, s[20:23], s57 offen sc1
  s_mov_b64 exec, -1
L_norep:
  s_waitcnt lgkmcnt(0)
  v_mfma_f32_16x16x32_bf16 v[40:43], v[96:99], v[64:67], 0
  v_mfma_f32_16x16x32_bf16 v[40:43], v[100:103], v[68:71], v[40:43]
  v_mfma_f32_16x16x32_bf16 v[40:43], v[104:107], v[72:75], v[40:43]
  v_mfma_f32_16x16x32_bf16 v[40:43], v[108:111], v[76:79], v[40:43]
  ds_read_b128 v[80:83], v33 offset:0
  ds_read_b128 v[84:87], v33 offset:64
  ds_read_b128 v[88:91], v33 offset:128
  ds_read_b128 v[92:95], v33 offset:192
  s_waitcnt lgkmcnt(4)
  v_mfma_f32_16x16x32_bf16 v[44:47], v[112:115], v[64:67], 0
  v_mfma_f32_16x16x32_bf16 v[44:47], v[116:119], v[68:71], v[44:47]
  v_mfma_f32_16x16x32_bf16 v[44:47], v[120:123], v[72:75], v[44:47]
  v_mfma_f32_16x16x32_bf16 v[44:47], v[124:127], v[76:79], v[44:47]
  ds_read_b128 v[96:99], v20 offset:4096
  ds_read_b128 v[100:103], v21 offset:4096
  ds_read_b128 v[104:107], v22 offset:4096
  ds_read_b128 v[108:111], v23 offset:4096
  ds_read_b128 v[112:115], v20 offset:20480
  ds_read_b128 v[116:119], v21 offset:20480
  ds_read_b128 v[120:123], v22 offset:20480
  ds_read_b128 v[124:127], v23 offset:20480
  s_waitcnt lgkmcnt(4)
  v_mfma_f32_16x16x32_bf16 v[40:43], v[96:99], v[80:83], v[40:43]
  v_mfma_f32_16x16x32_bf16 v[40:43], v[100:103], v[84:87], v[40:43]
  v_mfma_f32_16x16x32_bf16 v[40:43], v[104:107], v[88:91], v[40:43]
  v_mfma_f32_16x16x32_bf16 v[40:43], v[108:111], v[92:95], v[40:43]
  ds_read_b128 v[64:67], v34 offset:0
  ds_read_b128 v[68:71], v34 offset:64
  ds_read_b128 v[72:75], v34 offset:128
  ds_read_b128 v[76:79], v34 offset:192
  s_waitcnt lgkmcnt(4)
  v_mfma_f32_16x16x32_bf16 v[44:47], v[112:115], v[80:83], v[44:47]
  v_mfma_f32_16x16x32_bf16 v[44:47], v[116:119], v[84:87], v[44:47]
  v_mfma_f32_16x16x32_bf16 v[44:47], v[120:123], v[88:91], v[44:47]
  v_mfma_f32_16x16x32_bf16 v[44:47], v[124:127], v[92:95], v[44:47]
  ds_read_b128 v[96:99], v20 offset:8192
  ds_read_b128 v[100:103], v21 offset:8192
  ds_read_b128 v[104:107], v22 offset:8192
  ds_read_b128 v[108:111], v23 offset:8192
  ds_read_b128 v[112:115], v20 offset:24576
  ds_read_b128 v[116:119], v21 offset:24576
  ds_read_b128 v[120:123], v22 offset:24576
  ds_read_b128 v[124:127], v23 offset:24576
  s_waitcnt lgkmcnt(4)
  v_mfma_f32_16x16x32_bf16 v[40:43], v[96:99], v[64:67], v[40:43]
  v_mfma_f32_16x16x32_bf16 v[40:43], v[100:103], v[68:71], v[40:43]
  v_mfma_f32_16x16x32_bf16 v[40:43], v[104:107], v[72:75], v[40:43]
  v_mfma_f32_16x16x32_bf16 v[40:43], v[108:111], v[76:79], v[40:43]
  ds_read_b128 v[80:83], v35 offset:0
  ds_read_b128 v[84:87], v35 offset:64
  ds_read_b128 v[88:91], v35 offset:128
  ds_read_b128 v[92:95], v35 offset:192
  s_waitcnt lgkmcnt(4)
  v_mfma_f32_16x16x32_bf16 v[44:47], v[112:115], v[64:67], v[44:47]
  v_mfma_f32_16x16x32_bf16 v[44:47], v[116:119], v[68:71], v[44:47]
  v_mfma_f32_16x16x32_bf16 v[44:47], v[120:123], v[72:75], v[44:47]
  v_mfma_f32_16x16x32_bf16 v[44:47], v[124:127], v[76:79], v[44:47]
  ds_read_b128 v[96:99], v20 offset:12288
  ds_read_b128 v[100:103], v21 offset:12288
  ds_read_b128 v[104:107], v22 offset:12288
  ds_read_b128 v[108:111], v23 offset:12288
  ds_read_b128 v[112:115], v20 offset:28672
  ds_read_b128 v[116:119], v21 offset:28672
  ds_read_b128 v[120:123], v22 offset:28672
  ds_read_b128 v[124:127], v23 offset:28672
  s_waitcnt lgkmcnt(4)
  v_mfma_f32_16x16x32_bf16 v[40:43], v[96:99], v[80:83], v[40:43]
  v_mfma_f32_16x16x32_bf16 v[40:43], v[100:103], v[84:87], v[40:43]
  v_mfma_f32_16x16x32_bf16 v[40:43], v[104:107], v[88:91], v[40:43]
  v_mfma_f32_16x16x32_bf16 v[40:43], v[108:111], v[92:95], v[40:43]
  s_waitcnt lgkmcnt(0)
  v_mfma_f32_16x16x32_bf16 v[44:47], v[112:115], v[80:83], v[44:47]
  v_mfma_f32_16x16x32_bf16 v[44:47], v[116:119], v[84:87], v[44:47]
  v_mfma_f32_16x16x32_bf16 v[44:47], v[120:123], v[88:91], v[44:47]
  v_mfma_f32_16x16x32_bf16 v[44:47], v[124:127], v[92:95], v[44:47]
  s_nop 7
  v_cvt_pk_bf16_f32 v28, v40, v41
  v_cvt_pk_bf16_f32 v29, v42, v43
  v_cvt_pk_bf16_f32 v30, v44, v45
  v_cvt_pk_bf16_f32 v31, v46, v47
  v_lshlrev_b32 v40, 16, v28
  v_and_b32 v41, 0xffff0000, v28
  v_lshlrev_b32 v42, 16, v29
  v_and_b32 v43, 0xffff0000, v29
  v_lshlrev_b32 v44, 16, v30
  v_and_b32 v45, 0xffff0000, v30
  v_lshlrev_b32 v46, 16, v31
  v_and_b32 v47, 0xffff0000, v31
  v_mul_f32 v40, s62, v40
  v_mul_f32 v41, s62, v41
  v_mul_f32 v42, s62, v42
  v_mul_f32 v43, s62, v43
  v_mul_f32 v44, s62, v44
  v_mul_f32 v45, s62, v45
  v_mul_f32 v46, s62, v46
  v_mul_f32 v47, s62, v47
  v_cvt_pk_bf16_f32 v28, v40, v41
  v_cvt_pk_bf16_f32 v29, v42, v43
  v_cvt_pk_bf16_f32 v30, v44, v45
  v_cvt_pk_bf16_f32 v31, v46, v47
  v_lshlrev_b32 v40, 16, v28
  v_and_b32 v41, 0xffff0000, v28
  v_lshlrev_b32 v42, 16, v29
  v_and_b32 v43, 0xffff0000, v29
  v_lshlrev_b32 v44, 16, v30
  v_and_b32 v45, 0xffff0000, v30
  v_lshlrev_b32 v46, 16, v31
  v_and_b32 v47, 0xffff0000, v31
  v_max3_f32 v28, v40, v41, v42
  v_max3_f32 v29, v43, v44, v45
  v_max3_f32 v28, v28, v46, v47
  v_max_f32 v28, v28, v29
  s_nop 1
  v_max_f32_dpp v28, v28, v28 row_ror:4 row_mask:0xf bank_mask:0xf
  s_nop 1
  v_max_f32_dpp v28, v28, v28 row_ror:8 row_mask:0xf bank_mask:0xf
  v_mov_b32 v29, v28
  s_nop 1
  v_permlane16_swap_b32 v28, v29
  s_nop 1
  v_max_f32 v28, v28, v29
  v_mov_b32 v29, v28
  s_nop 1
  v_permlane32_swap_b32 v28, v29
  s_nop 1
  v_max_f32 v28, v28, v29
  v_mul_f32 v36, s14, v28
  v_fma_f32 v40, v40, s14, -v36
  v_fma_f32 v41, v41, s14, -v36
  v_fma_f32 v42, v42, s14, -v36
  v_fma_f32 v43, v43, s14, -v36
  v_fma_f32 v44, v44, s14, -v36
  v_fma_f32 v45, v45, s14, -v36
  v_fma_f32 v46, v46, s14, -v36
  v_fma_f32 v47, v47, s14, -v36
  v_exp_f32 v40, v40
  v_exp_f32 v41, v41
  v_exp_f32 v42, v42
  v_exp_f32 v43, v43
  v_exp_f32 v44, v44
  v_exp_f32 v45, v45
  v_exp_f32 v46, v46
  v_exp_f32 v47, v47
  ds_write_b32 v18, v36
  v_cvt_pk_bf16_f32 v32, v40, v41
  v_cvt_pk_bf16_f32 v33, v42, v43
  v_cvt_pk_bf16_f32 v34, v44, v45
  v_cvt_pk_bf16_f32 v35, v46, v47
  ds_write_b64 v17, v[32:33]
  ds_write_b64 v17, v[34:35] offset:512
  v_add_f32 v28, v40, v41
  v_add_f32 v29, v42, v43
  v_add_f32 v30, v44, v45
  v_add_f32 v31, v46, v47
  v_add_f32 v28, v28, v29
  v_add_f32 v30, v30, v31
  v_add_f32 v28, v28, v30
  s_nop 1
  v_add_f32_dpp v28, v28, v28 row_ror:4 row_mask:0xf bank_mask:0xf
  s_nop 1
  v_add_f32_dpp v28, v28, v28 row_ror:8 row_mask:0xf bank_mask:0xf
  v_mov_b32 v29, v28
  s_nop 1
  v_permlane16_swap_b32 v28, v29
  s_nop 1
  v_add_f32 v28, v28, v29
  v_mov_b32 v29, v28
  s_nop 1
  v_permlane32_swap_b32 v28, v29
  s_nop 1
  v_add_f32 v28, v28, v29
  ds_write_b32 v18, v28 offset:64
  v_lshlrev_b32 v7, 4, v16
  v_add_u32 v7, 137216, v7
  v_mov_b32 v6, 137356
  v_mov_b32 v8, 1
  s_mov_b64 exec, 1
  ds_add_rtn_u32 v8, v6, v8
  s_mov_b64 exec, -1
  ds_read_b128 v[20:23], v7
  ds_read_b128 v[24:27], v7 offset:64
  s_add_u32 s15, s7, s12
  v_mov_b32 v37, s7
  v_mov_b32 v39, s15
  s_and_b32 s56, s63, 15
  s_lshl_b32 s59, s3, 6
  s_add_u32 s56, s56, s59
  s_lshl_b32 s56, s56, 4
  s_add_u32 s56, s56, 0x1000
  v_lshlrev_b32 v7, 8, v0
  s_waitcnt lgkmcnt(0)
  v_readfirstlane_b32 s59, v8
  s_cmp_lg_u32 s59, 3
  s_cbranch_scc1 L_noml
  v_max3_f32 v36, v20, v21, v22
  v_max_f32 v36, v36, v23
  v_sub_f32 v20, v20, v36
  v_sub_f32 v21, v21, v36
  v_sub_f32 v22, v22, v36
  v_sub_f32 v23, v23, v36
  v_exp_f32 v20, v20
  v_exp_f32 v21, v21
  v_exp_f32 v22, v22
  v_exp_f32 v23, v23
  s_nop 0
  v_mul_f32 v38, v20, v24
  v_fmac_f32 v38, v21, v25
  v_fmac_f32 v38, v22, v26
  v_fmac_f32 v38, v23, v27
  s_mov_b64 exec, 15
  s_cmp_eq_u32 s13, 0
  s_cbranch_scc1 L_tl0
  buffer_store_dwordx4 v[36:39], v7, s[20:23], s56 offen sc1
  s_branch L_td0
L_tl0:
  buffer_store_dwordx4 v[36:39], v7, s[20:23], s56 offen
L_td0:
  s_mov_b64 exec, -1
L_noml:
  v_lshrrev_b32 v13, 3, v0
  v_lshlrev_b32 v12, 11, v13
  v_and_b32 v8, 7, v0
  v_lshl_add_u32 v12, v8, 4, v12
  v_lshlrev_b32 v13, 4, v13
  s_lshl_b32 s59, s6, 8
  s_add_u32 s59, s59, 137472
  v_and_b32 v17, 31, v0
  v_lshlrev_b32 v17, 3, v17
  v_add_u32 v17, s59, v17
  v_lshrrev_b32 v8, 5, v0
  v_lshl_add_u32 v17, v8, 2, v17
  v_lshlrev_b32 v8, 6, v16
  v_lshl_add_u32 v8, v1, 4, v8
  v_add_u32 v8, s59, v8
  v_mov_b32 v9, 132096
  v_cmp_eq_u32 vcc, 0, v5
  s_nop 1
  v_cndmask_b32 v208, v9, v8, vcc
  v_cmp_eq_u32 vcc, 1, v5
  s_nop 1
  v_cndmask_b32 v209, v9, v8, vcc
  v_cmp_eq_u32 vcc, 2, v5
  s_nop 1
  v_cndmask_b32 v210, v9, v8, vcc
  v_cmp_eq_u32 vcc, 3, v5
  s_nop 1
  v_cndmask_b32 v211, v9, v8, vcc
  s_lshl_b32 s59, s6, 11
  v_add_u32 v19, s59, v14
  s_lshl_b32 s59, s6, 9
  v_and_b32 v18, 31, v0
  v_lshlrev_b32 v18, 4, v18
  v_add_u32 v18, s59, v18
  v_mov_b32 v9, s7
  v_mov_b32 v11, s7
  s_lshr_b32 s58, s5, 2
  s_and_b32 s59, s5, 3
  s_lshl2_add_u32 s52, s3, s58
  s_lshl_b32 s52, s52, 8
  s_add_u32 s52, s52, 0x1000
  s_lshl_b32 s50, s3, 15
  s_lshl_b32 s53, s58, 9
  s_add_u32 s50, s50, s53
  s_lshl_b32 s53, s6, 7
  s_add_u32 s50, s50, s53
  s_add_u32 s50, s50, 0x40000
  s_add_u32 s51, s50, 16384
  s_lshl_b32 s57, s3, 2
  s_add_u32 s57, s57, s58
  s_lshl_b32 s53, s59, 6
  s_add_u32 s53, s53, s57
  s_lshl_b32 s53, s53, 11
  s_lshl_b32 s56, s6, 9
  s_add_u32 s53, s53, s56
  s_add_u32 s53, s53, 0xc0000
  s_lshl2_add_u32 s58, s4, s58
  s_lshl_b32 s58, s58, 17
  s_add_u32 s58, s58, s55
  s_lshl_b32 s59, s59, 8
  s_add_u32 s58, s58, s59
  s_lshr_b32 s57, s42, 1
  s_and_b32 s56, s2, 1
  s_lshr_b32 s59, s2, 7
  s_lshl1_add_u32 s56, s59, s56
  s_bfe_u32 s59, s2, 0x20005
  s_lshl2_add_u32 s56, s56, s59
  s_bfe_u32 s59, s2, 0x20003
  s_lshl2_add_u32 s56, s56, s59
  s_lshl_b32 s56, s56, 1
  s_lshl_b32 s97, s57, 17
  s_lshl_b32 s59, s56, 4
  s_add_u32 s97, s97, s59
  s_add_u32 s97, s97, 0xc0000
  s_add_u32 s98, s97, 65536
  v_lshrrev_b32 v212, 1, v0
  v_lshlrev_b32 v212, 11, v212
  v_and_b32 v7, 1, v0
  v_lshl_add_u32 v212, v7, 4, v212
  v_lshrrev_b32 v7, 5, v0
  v_add_u32 v4, s56, v7
  v_and_b32 v7, 3, v4
  v_lshlrev_b32 v226, 3, v7
  v_add_u32 v226, 137408, v226
  v_lshlrev_b32 v213, 9, v7
  s_lshl_b32 s57, s57, 7
  v_add_u32 v213, s57, v213
  v_bfe_u32 v7, v4, 4, 2
  v_lshl_add_u32 v213, v7, 5, v213
  v_lshrrev_b32 v7, 6, v4
  v_lshl_add_u32 v213, v7, 2, v213
  v_bfe_u32 v7, v4, 2, 2
  v_add_u32 v213, v213, v7
  v_lshl_add_u32 v213, v16, 3, v213
  v_lshlrev_b32 v213, 1, v213
  v_and_b32 v7, 1, v0
  v_lshlrev_b32 v7, 4, v7
  v_mov_b32 v6, 0x3f80
  v_lshlrev_b32 v6, v7, v6
  v_lshrrev_b32 v7, 1, v2
  v_cmp_eq_u32 vcc, 0, v7
  s_nop 1
  v_cndmask_b32 v232, 0, v6, vcc
  v_cmp_eq_u32 vcc, 1, v7
  s_nop 1
  v_cndmask_b32 v233, 0, v6, vcc
  v_cmp_eq_u32 vcc, 2, v7
  s_nop 1
  v_cndmask_b32 v234, 0, v6, vcc
  v_cmp_eq_u32 vcc, 3, v7
  s_nop 1
  v_cndmask_b32 v235, 0, v6, vcc
  s_bfe_u32 s34, s2, 0x10003
  s_lshl1_add_u32 s34, s34, s6
  s_sub_u32 s34, s34, 1
  s_lshl_b32 s35, s34, 10
  s_mov_b64 s[36:37], s[40:41]
  s_mov_b32 s38, 4096
  s_mov_b32 s39, 0x20000
  s_mov_b64 s[28:29], s[44:45]
  s_mov_b32 s30, 1024
  s_mov_b32 s31, 0x20000
  s_add_u32 s33, s6, 1
  s_barrier
  buffer_load_dwordx4 v[216:219], v13, s[20:23], s52 offen sc1 nt
  buffer_load_dwordx4 v[220:223], v13, s[20:23], s52 offen offset:128 sc1 nt
  s_add_u32 s59, s58, 0
  buffer_load_dwordx4 v[128:131], v15, s[16:19], s59 offen nt
  s_add_u32 s59, s58, 8192
  buffer_load_dwordx4 v[132:135], v15, s[16:19], s59 offen nt
  s_add_u32 s59, s58, 16384
  buffer_load_dwordx4 v[136:139], v15, s[16:19], s59 offen nt
  s_add_u32 s59, s58, 24576
  buffer_load_dwordx4 v[140:143], v15, s[16:19], s59 offen nt
  s_add_u32 s59, s58, 4096
  buffer_load_dwordx4 v[144:147], v15, s[16:19], s59 offen nt
  s_add_u32 s59, s58, 12288
  buffer_load_dwordx4 v[148:151], v15, s[16:19], s59 offen nt
  s_add_u32 s59, s58, 20480
  buffer_load_dwordx4 v[152:155], v15, s[16:19], s59 offen nt
  s_add_u32 s59, s58, 28672
  buffer_load_dwordx4 v[156:159], v15, s[16:19], s59 offen nt
  s_waitcnt vmcnt(8)
  v_xor_b32 v6, s7, v217
  v_bitop3_b32 v6, v221, s7, v6 bitop3:0xbe
  v_cmp_ne_u32 vcc, 0, v6
  s_mov_b32 s62, 0
  s_cbranch_vccnz L_mllate
  v_max_f32 v6, v216, v220
  v_mov_b32 v7, v6
  s_nop 1
  v_permlane32_swap_b32 v6, v7
  s_nop 1
  v_max_f32 v6, v6, v7
  v_sub_f32 v224, v216, v6
  v_sub_f32 v225, v220, v6
  v_exp_f32 v224, v224
  v_exp_f32 v225, v225
  s_nop 0
  v_mul_f32 v6, v224, v218
  v_fmac_f32 v6, v225, v222
  v_mov_b32 v7, v6
  s_nop 1
  v_permlane32_swap_b32 v6, v7
  s_nop 1
  v_add_f32 v6, v6, v7
  v_rcp_f32 v6, v6
  s_nop 0
  v_mul_f32 v224, v224, v6
  v_mul_f32 v225, v225, v6
  s_mov_b32 s62, 1
L_mllate:
  s_waitcnt vmcnt(6)
  v_perm_b32 v160, v132, v128, s60
  v_perm_b32 v164, v132, v128, s61
  v_perm_b32 v168, v133, v129, s60
  v_perm_b32 v172, v133, v129, s61
  v_perm_b32 v176, v134, v130, s60
  v_perm_b32 v180, v134, v130, s61
  v_perm_b32 v184, v135, v131, s60
  v_perm_b32 v188, v135, v131, s61
  s_waitcnt vmcnt(4)
  v_perm_b32 v161, v140, v136, s60
  v_perm_b32 v165, v140, v136, s61
  v_perm_b32 v169, v141, v137, s60
  v_perm_b32 v173, v141, v137, s61
  v_perm_b32 v177, v142, v138, s60
  v_perm_b32 v181, v142, v138, s61
  v_perm_b32 v185, v143, v139, s60
  v_perm_b32 v189, v143, v139, s61
  s_waitcnt vmcnt(2)
  v_perm_b32 v162, v148, v144, s60
  v_perm_b32 v166, v148, v144, s61
  v_perm_b32 v170, v149, v145, s60
  v_perm_b32 v174, v149, v145, s61
  v_perm_b32 v178, v150, v146, s60
  v_perm_b32 v182, v150, v146, s61
  v_perm_b32 v186, v151, v147, s60
  v_perm_b32 v190, v151, v147, s61
  s_waitcnt vmcnt(0)
  buffer_load_dwordx4 v[20:23], v12, s[20:23], s50 offen sc1 nt
  buffer_load_dwordx4 v[24:27], v12, s[20:23], s51 offen sc1 nt
  v_perm_b32 v163, v156, v152, s60
  v_perm_b32 v167, v156, v152, s61
  v_perm_b32 v171, v157, v153, s60
  v_perm_b32 v175, v157, v153, s61
  v_perm_b32 v179, v158, v154, s60
  v_perm_b32 v183, v158, v154, s61
  v_perm_b32 v187, v159, v155, s60
  v_perm_b32 v191, v159, v155, s61
  s_mov_b32 s59, 200000
  s_cmp_eq_u32 s62, 1
  s_cbranch_scc1 L_poll1
L_pollml:
  buffer_load_dwordx4 v[216:219], v13, s[20:23], s52 offen sc1 nt
  buffer_load_dwordx4 v[220:223], v13, s[20:23], s52 offen offset:128 sc1 nt
  s_waitcnt vmcnt(0)
  v_xor_b32 v6, s7, v217
  v_bitop3_b32 v6, v221, s7, v6 bitop3:0xbe
  v_cmp_ne_u32 vcc, 0, v6
  s_cbranch_vccz L_gotml
  s_sub_u32 s59, s59, 1
  s_cbranch_scc0 L_pollml
L_gotml:
  v_max_f32 v6, v216, v220
  v_mov_b32 v7, v6
  s_nop 1
  v_permlane32_swap_b32 v6, v7
  s_nop 1
  v_max_f32 v6, v6, v7
  v_sub_f32 v224, v216, v6
  v_sub_f32 v225, v220, v6
  v_exp_f32 v224, v224
  v_exp_f32 v225, v225
  s_nop 0
  v_mul_f32 v6, v224, v218
  v_fmac_f32 v6, v225, v222
  v_mov_b32 v7, v6
  s_nop 1
  v_permlane32_swap_b32 v6, v7
  s_nop 1
  v_add_f32 v6, v6, v7
  v_rcp_f32 v6, v6
  s_nop 0
  v_mul_f32 v224, v224, v6
  v_mul_f32 v225, v225, v6
L_poll1:
  s_waitcnt vmcnt(0)
  v_xor_b32 v6, s7, v21
  v_xor_b32 v7, s7, v23
  v_bitop3_b32 v6, v25, s7, v6 bitop3:0xbe
  v_bitop3_b32 v7, v27, s7, v7 bitop3:0xbe
  v_or_b32 v6, v6, v7
  v_cmp_ne_u32 vcc, 0, v6
  s_cbranch_vccz L_got1
  s_sub_u32 s59, s59, 1
  s_cbranch_scc1 L_got1
  s_mov_b64 exec, vcc
  buffer_load_dwordx4 v[20:23], v12, s[20:23], s50 offen sc1 nt
  buffer_load_dwordx4 v[24:27], v12, s[20:23], s51 offen sc1 nt
  s_branch L_poll1
L_got1:
  s_mov_b64 exec, -1
  v_lshlrev_b32 v28, 16, v20
  v_and_b32 v29, 0xffff0000, v20
  v_lshlrev_b32 v30, 16, v22
  v_and_b32 v31, 0xffff0000, v22
  v_lshlrev_b32 v36, 16, v24
  v_and_b32 v37, 0xffff0000, v24
  v_lshlrev_b32 v38, 16, v26
  v_and_b32 v39, 0xffff0000, v26
  v_pk_mul_f32 v[28:29], v[28:29], v[224:225] op_sel_hi:[1,0]
  v_pk_mul_f32 v[30:31], v[30:31], v[224:225] op_sel_hi:[1,0]
  v_pk_fma_f32 v[28:29], v[36:37], v[224:225], v[28:29] op_sel:[0,1,0] op_sel_hi:[1,1,1]
  v_pk_fma_f32 v[30:31], v[38:39], v[224:225], v[30:31] op_sel:[0,1,0] op_sel_hi:[1,1,1]
  s_nop 1
  v_permlane32_swap_b32 v28, v30
  v_permlane32_swap_b32 v29, v31
  s_nop 0
  v_pk_add_f32 v[28:29], v[28:29], v[30:31]
  v_cvt_pk_bf16_f32 v20, v28, v29
  ds_write_b32 v17, v20
  ds_read_b128 v[48:51], v208
  ds_read_b128 v[52:55], v209
  ds_read_b128 v[56:59], v210
  ds_read_b128 v[60:63], v211
  s_waitcnt lgkmcnt(3)
  v_mfma_f32_16x16x32_bf16 v[40:43], v[160:163], v[48:51], 0
  v_mfma_f32_16x16x32_bf16 v[44:47], v[176:179], v[48:51], 0
  s_waitcnt lgkmcnt(2)
  v_mfma_f32_16x16x32_bf16 v[40:43], v[164:167], v[52:55], v[40:43]
  v_mfma_f32_16x16x32_bf16 v[44:47], v[180:183], v[52:55], v[44:47]
  s_waitcnt lgkmcnt(1)
  v_mfma_f32_16x16x32_bf16 v[40:43], v[168:171], v[56:59], v[40:43]
  v_mfma_f32_16x16x32_bf16 v[44:47], v[184:187], v[56:59], v[44:47]
  s_waitcnt lgkmcnt(0)
  v_mfma_f32_16x16x32_bf16 v[40:43], v[172:175], v[60:63], v[40:43]
  v_mfma_f32_16x16x32_bf16 v[44:47], v[188:191], v[60:63], v[44:47]
  s_bitcmp1_b32 s33, 1
  s_cbranch_scc0 L_ng
  buffer_load_dwordx4 v[128:131], v14, s[36:39], s35 offen
  buffer_load_dwordx4 v[132:135], v14, s[28:31], 0 offen
L_ng:
  s_nop 4
  ds_write_b128 v19, v[40:43]
  ds_write_b128 v19, v[44:47] offset:1024
  s_waitcnt lgkmcnt(0)
  s_barrier
  ds_read_b128 v[20:23], v18 offset:0
  ds_read_b128 v[24:27], v18 offset:2048
  ds_read_b128 v[28:31], v18 offset:4096
  ds_read_b128 v[32:35], v18 offset:6144
  s_waitcnt lgkmcnt(2)
  v_pk_add_f32 v[20:21], v[20:21], v[24:25]
  v_pk_add_f32 v[22:23], v[22:23], v[26:27]
  s_waitcnt lgkmcnt(1)
  v_pk_add_f32 v[20:21], v[20:21], v[28:29]
  v_pk_add_f32 v[22:23], v[22:23], v[30:31]
  s_waitcnt lgkmcnt(0)
  v_pk_add_f32 v[20:21], v[20:21], v[32:33]
  v_pk_add_f32 v[22:23], v[22:23], v[34:35]
  v_cvt_pk_bf16_f32 v8, v20, v21
  v_cvt_pk_bf16_f32 v10, v22, v23
  s_mov_b32 exec_hi, 0
  buffer_store_dwordx4 v[8:11], v14, s[20:23], s53 offen sc1
  s_mov_b32 exec_hi, -1
  s_cmp_lg_u32 s6, 0
  s_cbranch_scc1 L_gate
  s_waitcnt vmcnt(0)
  s_mov_b32 s59, 200000
L_poll2:
  buffer_load_dwordx4 v[20:23], v212, s[20:23], s97 offen sc1
  buffer_load_dwordx4 v[24:27], v212, s[20:23], s98 offen sc1
  s_waitcnt vmcnt(0)
  v_xor_b32 v6, s7, v21
  v_xor_b32 v7, s7, v23
  v_bitop3_b32 v6, v25, s7, v6 bitop3:0xbe
  v_bitop3_b32 v7, v27, s7, v7 bitop3:0xbe
  v_or_b32 v6, v6, v7
  v_cmp_ne_u32 vcc, 0, v6
  s_cbranch_vccz L_got2
  s_sub_u32 s59, s59, 1
  s_cbranch_scc1 L_got2
  s_mov_b64 exec, vcc
  s_branch L_poll2
L_got2:
  s_mov_b64 exec, -1
  ds_read_b64 v[214:215], v226
  s_mov_b32 s59, 200000
  v_mov_b32 v21, v22
  v_mov_b32 v22, v24
  v_mov_b32 v23, v26
  s_nop 1
  v_mfma_f32_16x16x32_bf16 v[28:31], v[20:23], v[232:235], 0
  s_nop 7
  v_pk_add_f32 v[28:29], v[28:29], v[30:31]
  s_waitcnt lgkmcnt(0)
  v_or_b32 v7, v214, v215
  v_permlane32_swap_b32 v28, v29
  v_cmp_eq_u32 vcc, 0, v7
  v_add_f32 v28, v28, v29
  v_mov_b32 v29, v28
  s_nop 1
  v_permlane16_swap_b32 v28, v29
  s_nop 0
  v_add_f32 v20, v28, v29
  s_nop 1
  v_mov_b32_dpp v21, v20 row_ror:12 row_mask:0xf bank_mask:0xf
  v_cvt_pk_bf16_f32 v20, v20, v21
  v_lshlrev_b32 v21, 16, v20
  v_and_b32 v22, 0xffff0000, v20
  s_cbranch_vccnz L_glate
L_gok:
  v_mul_f32 v21, v21, v214
  v_mul_f32 v22, v22, v215
  v_cvt_pk_bf16_f32 v20, v21, v22
  v_lshlrev_b32 v21, 16, v20
  v_and_b32 v22, 0xffff0000, v20
  v_add_f32 v21, v21, v22
  v_cvt_pk_bf16_f32 v20, v21, v21
  s_mov_b32 exec_lo, 15
  s_mov_b32 exec_hi, 15
  buffer_store_short v20, v213, s[24:27], 0 offen
  s_cmp_lg_u32 s2, 0
  s_cbranch_scc1 L_fin
  s_mov_b64 exec, 1
  v_mov_b32 v6, s7
  buffer_store_dword v6, v14, s[20:23], 0 offen offset:0
L_fin:
  s_endpgm
L_glate:
  ds_read_b64 v[214:215], v226
  s_waitcnt lgkmcnt(0)
  v_or_b32 v7, v214, v215
  v_cmp_eq_u32 vcc, 0, v7
  s_cbranch_vccz L_gok
  s_sub_u32 s59, s59, 1
  s_cbranch_scc0 L_glate
  s_branch L_gok
L_gate:
  s_cmp_eq_u32 s6, 3
  s_cbranch_scc1 L_end
  s_mov_b32 s56, s34
  s_waitcnt vmcnt(1)
  v_lshlrev_b32 v36, 16, v128
  v_and_b32 v37, 0xffff0000, v128
  v_lshlrev_b32 v38, 16, v132
  v_and_b32 v39, 0xffff0000, v132
  v_mul_f32 v36, v36, v38
  v_mul_f32 v37, v37, v39
  v_cvt_pk_bf16_f32 v36, v36, v37
  v_lshlrev_b32 v136, 16, v36
  v_and_b32 v137, 0xffff0000, v36
  v_lshlrev_b32 v36, 16, v129
  v_and_b32 v37, 0xffff0000, v129
  v_lshlrev_b32 v38, 16, v133
  v_and_b32 v39, 0xffff0000, v133
  v_mul_f32 v36, v36, v38
  v_mul_f32 v37, v37, v39
  v_cvt_pk_bf16_f32 v36, v36, v37
  v_lshlrev_b32 v38, 16, v36
  v_and_b32 v39, 0xffff0000, v36
  v_add_f32 v136, v136, v38
  v_add_f32 v137, v137, v39
  v_lshlrev_b32 v36, 16, v130
  v_and_b32 v37, 0xffff0000, v130
  v_lshlrev_b32 v38, 16, v134
  v_and_b32 v39, 0xffff0000, v134
  v_mul_f32 v36, v36, v38
  v_mul_f32 v37, v37, v39
  v_cvt_pk_bf16_f32 v36, v36, v37
  v_lshlrev_b32 v38, 16, v36
  v_and_b32 v39, 0xffff0000, v36
  v_add_f32 v136, v136, v38
  v_add_f32 v137, v137, v39
  v_lshlrev_b32 v36, 16, v131
  v_and_b32 v37, 0xffff0000, v131
  v_lshlrev_b32 v38, 16, v135
  v_and_b32 v39, 0xffff0000, v135
  v_mul_f32 v36, v36, v38
  v_mul_f32 v37, v37, v39
  v_cvt_pk_bf16_f32 v36, v36, v37
  v_lshlrev_b32 v38, 16, v36
  v_and_b32 v39, 0xffff0000, v36
  v_add_f32 v136, v136, v38
  v_add_f32 v137, v137, v39
  v_add_f32 v136, v136, v137
  s_nop 1
  v_add_f32_dpp v136, v136, v136 quad_perm:[1,0,3,2] row_mask:0xf bank_mask:0xf
  s_nop 1
  v_add_f32_dpp v136, v136, v136 quad_perm:[2,3,0,1] row_mask:0xf bank_mask:0xf
  s_nop 1
  v_add_f32_dpp v136, v136, v136 row_ror:4 row_mask:0xf bank_mask:0xf
  s_nop 1
  v_add_f32_dpp v136, v136, v136 row_ror:8 row_mask:0xf bank_mask:0xf
  v_mov_b32 v137, v136
  s_nop 1
  v_permlane16_swap_b32 v136, v137
  s_nop 1
  v_add_f32 v136, v136, v137
  v_mov_b32 v137, v136
  s_nop 1
  v_permlane32_swap_b32 v136, v137
  s_nop 1
  v_add_f32 v136, v136, v137
  v_cvt_pk_bf16_f32 v136, v136, v136
  v_lshlrev_b32 v136, 16, v136
  v_mul_f32 v136, 0xbfb8aa3b, v136
  v_exp_f32 v136, v136
  s_nop 0
  v_add_f32 v136, 1.0, v136
  v_rcp_f32 v136, v136
  s_nop 0
  v_cvt_pk_bf16_f32 v136, v136, v136
  v_lshlrev_b32 v136, 16, v136
  v_sub_f32 v137, 1.0, v136
  v_cvt_pk_bf16_f32 v137, v137, v137
  v_lshlrev_b32 v137, 16, v137
  s_lshl_b32 s59, s56, 3
  s_add_u32 s59, s59, 137408
  v_mov_b32 v6, s59
  ds_write_b64 v6, v[136:137]
  s_endpgm
  .p2align 6
L_vwave:
  s_setprio 3
  s_and_b32 s6, s6, 3
  s_lshr_b32 s58, s2, 6
  s_and_b32 s4, s2, 7
  s_lshl3_add_u32 s54, s58, s4
  s_lshr_b32 s5, s2, 4
  s_and_b32 s59, s5, 3
  s_lshl2_add_u32 s54, s54, 3
  s_lshl_b32 s54, s54, 7
  s_lshl2_add_u32 s59, s59, s6
  s_add_u32 s54, s54, s59
  s_lshl_b32 s54, s54, 12
  s_lshl_b32 s96, s2, 29
  s_lshl_b32 s97, 1, 29
  s_lshl_b32 s10, 1, 26
  s_mov_b32 s11, 0x20000
  s_lshr_b32 s59, s5, 1
  s_cmp_eq_u32 s59, 3
  s_cselect_b32 s98, 1, 0
  s_and_b32 s3, s2, 15
  s_and_b32 s59, s5, 3
  s_and_b32 s42, s2, 7
  s_mov_b32 s60, 0x05040100
  s_mov_b32 s61, 0x07060302
  s_mov_b32 s18, 0x400000
  s_mov_b32 s19, 0x20000
  s_mov_b32 s22, 285221888
  s_mov_b32 s23, 0x20000
  s_mov_b32 s26, 4096
  s_mov_b32 s27, 0x20000
  s_lshl_b32 s55, s6, 15
  s_lshl2_add_u32 s63, s59, s58
  s_lshl4_add_u32 s63, s3, s63
  s_getreg_b32 s12, hwreg(HW_REG_XCC_ID, 0, 3)
  v_lshrrev_b32 v1, 4, v0
  v_and_b32 v2, 15, v0
  v_bfe_u32 v5, v0, 2, 2
  v_and_b32 v16, 3, v0
  s_lshl_b32 s57, s6, 8
  s_add_u32 s57, s57, 132096
  v_lshlrev_b32 v4, 2, v0
  v_add_u32 v7, s57, v4
  v_mov_b32 v6, 0
  v_and_b32 v4, 0x7c, v4
  v_add_u32 v4, 137344, v4
  ds_write_b32 v7, v6
  ds_write_b32 v4, v6
  v_lshrrev_b32 v8, 3, v0
  v_and_b32 v7, 7, v0
  v_lshlrev_b32 v9, 16, v8
  v_lshl_add_u32 v9, v7, 4, v9
  s_and_b32 s57, s5, 1
  s_lshl2_add_u32 s57, s57, s6
  s_lshl_b32 s56, s57, 12
  s_lshr_b32 s59, s5, 1
  s_lshl3_add_u32 s59, s4, s59
  s_add_u32 s56, s56, s59
  s_lshl_b32 s56, s56, 7
  s_lshl_b32 s57, s57, 7
  v_lshlrev_b32 v8, 4, v8
  v_lshl_add_u32 v8, v16, 10, v8
  s_waitcnt lgkmcnt(0)
  s_mov_b64 s[16:17], s[36:37]
  s_mov_b64 s[24:25], s[40:41]
  buffer_load_dwordx4 v[64:67], v9, s[16:19], s56 offen nt
  s_addk_i32 s56, 0x2000
  buffer_load_dwordx4 v[68:71], v9, s[16:19], s56 offen nt
  s_addk_i32 s56, 0x2000
  buffer_load_dwordx4 v[72:75], v9, s[16:19], s56 offen nt
  s_addk_i32 s56, 0x2000
  buffer_load_dwordx4 v[76:79], v9, s[16:19], s56 offen nt
  s_addk_i32 s56, 0x2000
  buffer_load_dwordx4 v[80:83], v9, s[16:19], s56 offen nt
  s_addk_i32 s56, 0x2000
  buffer_load_dwordx4 v[84:87], v9, s[16:19], s56 offen nt
  s_addk_i32 s56, 0x2000
  buffer_load_dwordx4 v[88:91], v9, s[16:19], s56 offen nt
  s_addk_i32 s56, 0x2000
  buffer_load_dwordx4 v[92:95], v9, s[16:19], s56 offen nt
  buffer_load_dwordx4 v[104:107], v8, s[24:27], s57 offen
  s_barrier
  s_load_dword s7, s[50:51], 0x0
  s_mov_b64 s[20:21], s[50:51]
  s_mov_b64 s[8:9], s[34:35]
  s_lshl_b32 s59, s6, 11
  s_add_u32 s59, s59, 138496
  v_add_u32 v19, s59, v14
  v_lshlrev_b32 v17, 9, v1
  v_lshl_add_u32 v17, v7, 4, v17
  v_add_u32 v17, s59, v17
  v_bfe_u32 v12, v0, 1, 4
  v_lshlrev_b32 v12, 6, v12
  v_and_b32 v8, 1, v0
  v_lshl_add_u32 v12, v8, 10, v12
  s_lshl_b32 s59, s6, 4
  s_add_u32 s59, s59, 138496
  v_add_u32 v12, s59, v12
  v_lshlrev_b32 v18, 11, v1
  v_lshl_add_u32 v18, v2, 6, v18
  v_add_u32 v18, s59, v18
  v_add_u32 v15, s54, v14
  v_mov_b32 v10, 137344
  v_mov_b32 v11, 1
  s_lshl2_add_u32 s57, s3, s6
  s_lshl4_add_u32 s57, s57, s5
  s_lshl_b32 s57, s57, 8
  s_add_u32 s57, s57, 0x140000
  v_and_b32 v8, 4, v0
  v_cmp_eq_u32 vcc, 0, v8
  s_waitcnt vmcnt(0) lgkmcnt(0)
  s_add_u32 s7, s7, 0x9e3779b1
  v_cndmask_b32 v96, 0, v104, vcc
  v_cndmask_b32 v100, v104, 0, vcc
  v_cndmask_b32 v97, 0, v105, vcc
  v_cndmask_b32 v101, v105, 0, vcc
  v_cndmask_b32 v98, 0, v106, vcc
  v_cndmask_b32 v102, v106, 0, vcc
  v_cndmask_b32 v99, 0, v107, vcc
  v_cndmask_b32 v103, v107, 0, vcc
  v_perm_b32 v32, v68, v64, s60
  v_perm_b32 v33, v76, v72, s60
  v_perm_b32 v34, v84, v80, s60
  v_perm_b32 v35, v92, v88, s60
  v_perm_b32 v36, v68, v64, s61
  v_perm_b32 v37, v76, v72, s61
  v_perm_b32 v38, v84, v80, s61
  v_perm_b32 v39, v92, v88, s61
  v_mfma_f32_16x16x32_bf16 v[112:115], v[32:35], v[96:99], 0
  v_perm_b32 v40, v69, v65, s60
  v_perm_b32 v41, v77, v73, s60
  v_perm_b32 v42, v85, v81, s60
  v_perm_b32 v43, v93, v89, s60
  v_mfma_f32_16x16x32_bf16 v[112:115], v[36:39], v[100:103], v[112:115]
  v_perm_b32 v44, v69, v65, s61
  v_perm_b32 v45, v77, v73, s61
  v_perm_b32 v46, v85, v81, s61
  v_perm_b32 v47, v93, v89, s61
  v_mfma_f32_16x16x32_bf16 v[116:119], v[40:43], v[96:99], 0
  v_perm_b32 v48, v70, v66, s60
  v_perm_b32 v49, v78, v74, s60
  v_perm_b32 v50, v86, v82, s60
  v_perm_b32 v51, v94, v90, s60
  v_mfma_f32_16x16x32_bf16 v[116:119], v[44:47], v[100:103], v[116:119]
  v_perm_b32 v52, v70, v66, s61
  v_perm_b32 v53, v78, v74, s61
  v_perm_b32 v54, v86, v82, s61
  v_perm_b32 v55, v94, v90, s61
  v_mfma_f32_16x16x32_bf16 v[120:123], v[48:51], v[96:99], 0
  v_perm_b32 v56, v71, v67, s60
  v_perm_b32 v57, v79, v75, s60
  v_perm_b32 v58, v87, v83, s60
  v_perm_b32 v59, v95, v91, s60
  v_mfma_f32_16x16x32_bf16 v[120:123], v[52:55], v[100:103], v[120:123]
  v_perm_b32 v60, v71, v67, s61
  v_perm_b32 v61, v79, v75, s61
  v_perm_b32 v62, v87, v83, s61
  v_perm_b32 v63, v95, v91, s61
  v_mfma_f32_16x16x32_bf16 v[124:127], v[56:59], v[96:99], 0
  s_nop 1
  v_mfma_f32_16x16x32_bf16 v[124:127], v[60:63], v[100:103], v[124:127]
  s_mov_b32 exec_lo, 0x00ff00ff
  s_mov_b32 exec_hi, 0xff00ff00
  s_nop 6
  ds_write_b128 v17, v[112:115] offset:0
  ds_write_b128 v17, v[116:119] offset:128
  ds_write_b128 v17, v[120:123] offset:256
  ds_write_b128 v17, v[124:127] offset:384
  s_mov_b64 exec, 1
  ds_add_u32 v10, v11
  s_mov_b64 exec, -1
  s_add_u32 s59, s7, s12
  s_mov_b32 s56, 0x07060503
  s_mov_b32 s58, 0x07060502
  s_mov_b32 s62, 0x07060501
  v_mov_b32 v67, s59
  s_mov_b32 s59, 200000
L_xspin:
  ds_read_b32 v4, v10
  ds_read_b128 v[32:35], v18 offset:0
  ds_read_b128 v[36:39], v18 offset:1024
  s_waitcnt lgkmcnt(2)
  v_readfirstlane_b32 s53, v4
  s_cmp_eq_u32 s53, 4
  s_cbranch_scc1 L_xall
  s_sub_u32 s59, s59, 1
  s_cbranch_scc0 L_xspin
L_xall:
  s_waitcnt lgkmcnt(0)
  v_add_f32 v32, v32, v36
  v_add_f32 v33, v33, v37
  v_add_f32 v34, v34, v38
  v_add_f32 v35, v35, v39
  v_mov_b32 v36, v32
  v_mov_b32 v37, v33
  v_mov_b32 v38, v34
  v_mov_b32 v39, v35
  s_nop 0
  v_permlane32_swap_b32 v32, v36
  v_permlane32_swap_b32 v33, v37
  v_permlane32_swap_b32 v34, v38
  v_permlane32_swap_b32 v35, v39
  s_nop 0
  v_add_f32 v32, v32, v36
  v_add_f32 v33, v33, v37
  v_add_f32 v34, v34, v38
  v_add_f32 v35, v35, v39
  v_mov_b32 v36, v32
  v_mov_b32 v37, v33
  v_mov_b32 v38, v34
  v_mov_b32 v39, v35
  s_nop 0
  v_permlane16_swap_b32 v32, v36
  v_permlane16_swap_b32 v33, v37
  v_permlane16_swap_b32 v34, v38
  v_permlane16_swap_b32 v35, v39
  s_nop 0
  v_add_f32 v32, v32, v36
  v_add_f32 v33, v33, v37
  v_add_f32 v34, v34, v38
  v_add_f32 v35, v35, v39
  v_perm_b32 v64, v32, v35, s56
  v_perm_b32 v65, v33, v35, s58
  v_perm_b32 v66, v34, v35, s62
  s_mov_b64 exec, 0xffff
  s_cmp_eq_u32 s12, s42
  s_cbranch_scc1 L_ql
  buffer_store_dwordx4 v[64:67], v14, s[20:23], s57 offen sc1
  s_branch L_qd
L_ql:
  buffer_store_dwordx4 v[64:67], v14, s[20:23], s57 offen
L_qd:
  s_mov_b64 exec, -1
  v_lshl_add_u32 v8, v1, 2, v16
  s_lshl_b32 s57, s6, 10
  s_add_u32 s57, s57, 133120
  v_lshlrev_b32 v8, 4, v8
  v_add_u32 v8, s57, v8
  v_mov_b32 v9, 132096
  v_cmp_eq_u32 vcc, 0, v5
  s_nop 1
  v_cndmask_b32 v20, v9, v8, vcc
  v_cmp_eq_u32 vcc, 1, v5
  s_nop 1
  v_cndmask_b32 v21, v9, v8, vcc
  v_cmp_eq_u32 vcc, 2, v5
  s_nop 1
  v_cndmask_b32 v22, v9, v8, vcc
  v_cmp_eq_u32 vcc, 3, v5
  s_nop 1
  v_cndmask_b32 v23, v9, v8, vcc
  s_lshl_b32 s59, s6, 4
  s_add_u32 s59, s59, 137216
  v_mov_b32 v13, s59
  s_lshl_b32 s57, s63, 11
  s_lshl_b32 s59, s6, 9
  s_add_u32 s57, s57, s59
  s_add_u32 s57, s57, 0x40000
  v_mov_b32 v2, 137352
  v_mov_b32 v3, 1
  v_mov_b32 v9, s7
  v_mov_b32 v11, s7
  s_setprio 0
  s_barrier
  s_cmp_eq_u32 s98, 1
  s_cbranch_scc1 L_vs1
L_vs0:
  s_lshr_b32 s56, s96, 13
  s_add_u32 s96, s96, s97
  buffer_load_dwordx4 v[128:131], v15, s[8:11], s56 offen offset:0 nt
  buffer_load_dwordx4 v[132:135], v15, s[8:11], s56 offen offset:1024 nt
  buffer_load_dwordx4 v[136:139], v15, s[8:11], s56 offen offset:2048 nt
  buffer_load_dwordx4 v[140:143], v15, s[8:11], s56 offen offset:3072 nt
  s_lshr_b32 s56, s96, 13
  s_add_u32 s96, s96, s97
  buffer_load_dwordx4 v[144:147], v15, s[8:11], s56 offen offset:0 nt
  buffer_load_dwordx4 v[148:151], v15, s[8:11], s56 offen offset:1024 nt
  buffer_load_dwordx4 v[152:155], v15, s[8:11], s56 offen offset:2048 nt
  s_waitcnt vmcnt(6)
  buffer_load_dwordx4 v[156:159], v15, s[8:11], s56 offen offset:3072 nt
  s_lshr_b32 s56, s96, 13
  s_add_u32 s96, s96, s97
  s_waitcnt vmcnt(6)
  buffer_load_dwordx4 v[160:163], v15, s[8:11], s56 offen offset:0 nt
  s_waitcnt vmcnt(6)
  buffer_load_dwordx4 v[164:167], v15, s[8:11], s56 offen offset:1024 nt
  s_waitcnt vmcnt(6)
  buffer_load_dwordx4 v[168:171], v15, s[8:11], s56 offen offset:2048 nt
  s_waitcnt vmcnt(6)
  buffer_load_dwordx4 v[172:175], v15, s[8:11], s56 offen offset:3072 nt
  s_lshr_b32 s56, s96, 13
  s_add_u32 s96, s96, s97
  s_waitcnt vmcnt(6)
  buffer_load_dwordx4 v[176:179], v15, s[8:11], s56 offen offset:0 nt
  s_waitcnt vmcnt(6)
  buffer_load_dwordx4 v[180:183], v15, s[8:11], s56 offen offset:1024 nt
  s_waitcnt vmcnt(6)
  buffer_load_dwordx4 v[184:187], v15, s[8:11], s56 offen offset:2048 nt
  s_waitcnt vmcnt(6)
  buffer_load_dwordx4 v[188:191], v15, s[8:11], s56 offen offset:3072 nt
  s_lshr_b32 s56, s96, 13
  s_add_u32 s96, s96, s97
  s_waitcnt vmcnt(6)
  buffer_load_dwordx4 v[192:195], v15, s[8:11], s56 offen offset:0 nt
  s_waitcnt vmcnt(6)
  buffer_load_dwordx4 v[196:199], v15, s[8:11], s56 offen offset:1024 nt
  s_waitcnt vmcnt(6)
  buffer_load_dwordx4 v[200:203], v15, s[8:11], s56 offen offset:2048 nt
  s_waitcnt vmcnt(6)
  buffer_load_dwordx4 v[204:207], v15, s[8:11], s56 offen offset:3072 nt
  s_lshr_b32 s56, s96, 13
  s_add_u32 s96, s96, s97
  s_waitcnt vmcnt(6)
  buffer_load_dwordx4 v[208:211], v15, s[8:11], s56 offen offset:0 nt
  s_waitcnt vmcnt(6)
  buffer_load_dwordx4 v[212:215], v15, s[8:11], s56 offen offset:1024 nt
  s_waitcnt vmcnt(6)
  buffer_load_dwordx4 v[216:219], v15, s[8:11], s56 offen offset:2048 nt
  s_waitcnt vmcnt(6)
  buffer_load_dwordx4 v[220:223], v15, s[8:11], s56 offen offset:3072 nt
  s_lshr_b32 s56, s96, 13
  s_add_u32 s96, s96, s97
  s_waitcnt vmcnt(6)
  buffer_load_dwordx4 v[224:227], v15, s[8:11], s56 offen offset:0 nt
  s_waitcnt vmcnt(6)
  buffer_load_dwordx4 v[228:231], v15, s[8:11], s56 offen offset:1024 nt
  s_waitcnt vmcnt(6)
  buffer_load_dwordx4 v[232:235], v15, s[8:11], s56 offen offset:2048 nt
  s_waitcnt vmcnt(6)
  buffer_load_dwordx4 v[236:239], v15, s[8:11], s56 offen offset:3072 nt
  s_lshr_b32 s56, s96, 13
  s_add_u32 s96, s96, s97
  s_waitcnt vmcnt(6)
  buffer_load_dwordx4 v[240:243], v15, s[8:11], s56 offen offset:0 nt
  s_waitcnt vmcnt(6)
  buffer_load_dwordx4 v[244:247], v15, s[8:11], s56 offen offset:1024 nt
  s_waitcnt vmcnt(6)
  buffer_load_dwordx4 v[248:251], v15, s[8:11], s56 offen offset:2048 nt
  s_waitcnt vmcnt(6)
  buffer_load_dwordx4 v[252:255], v15, s[8:11], s56 offen offset:3072 nt
  s_branch L_vsd
L_vs1:
  s_lshr_b32 s56, s96, 13
  s_add_u32 s96, s96, s97
  buffer_load_dwordx4 v[128:131], v15, s[8:11], s56 offen offset:0 nt
  buffer_load_dwordx4 v[132:135], v15, s[8:11], s56 offen offset:1024 nt
  buffer_load_dwordx4 v[136:139], v15, s[8:11], s56 offen offset:2048 nt
  buffer_load_dwordx4 v[140:143], v15, s[8:11], s56 offen offset:3072 nt
  s_lshr_b32 s56, s96, 13
  s_add_u32 s96, s96, s97
  buffer_load_dwordx4 v[144:147], v15, s[8:11], s56 offen offset:0 nt
  buffer_load_dwordx4 v[148:151], v15, s[8:11], s56 offen offset:1024 nt
  buffer_load_dwordx4 v[152:155], v15, s[8:11], s56 offen offset:2048 nt
  buffer_load_dwordx4 v[156:159], v15, s[8:11], s56 offen offset:3072 nt
  s_lshr_b32 s56, s96, 13
  s_add_u32 s96, s96, s97
  buffer_load_dwordx4 v[160:163], v15, s[8:11], s56 offen offset:0 nt
  buffer_load_dwordx4 v[164:167], v15, s[8:11], s56 offen offset:1024 nt
  buffer_load_dwordx4 v[168:171], v15, s[8:11], s56 offen offset:2048 nt
  buffer_load_dwordx4 v[172:175], v15, s[8:11], s56 offen offset:3072 nt
  s_lshr_b32 s56, s96, 13
  s_add_u32 s96, s96, s97
  s_waitcnt vmcnt(11)
  buffer_load_dwordx4 v[176:179], v15, s[8:11], s56 offen offset:0 nt
  s_waitcnt vmcnt(11)
  buffer_load_dwordx4 v[180:183], v15, s[8:11], s56 offen offset:1024 nt
  s_waitcnt vmcnt(11)
  buffer_load_dwordx4 v[184:187], v15, s[8:11], s56 offen offset:2048 nt
  s_waitcnt vmcnt(11)
  buffer_load_dwordx4 v[188:191], v15, s[8:11], s56 offen offset:3072 nt
  s_lshr_b32 s56, s96, 13
  s_add_u32 s96, s96, s97
  s_waitcnt vmcnt(11)
  buffer_load_dwordx4 v[192:195], v15, s[8:11], s56 offen offset:0 nt
  s_waitcnt vmcnt(11)
  buffer_load_dwordx4 v[196:199], v15, s[8:11], s56 offen offset:1024 nt
  s_waitcnt vmcnt(11)
  buffer_load_dwordx4 v[200:203], v15, s[8:11], s56 offen offset:2048 nt
  s_waitcnt vmcnt(11)
  buffer_load_dwordx4 v[204:207], v15, s[8:11], s56 offen offset:3072 nt
  s_lshr_b32 s56, s96, 13
  s_add_u32 s96, s96, s97
  s_waitcnt vmcnt(11)
  buffer_load_dwordx4 v[208:211], v15, s[8:11], s56 offen offset:0 nt
  s_waitcnt vmcnt(11)
  buffer_load_dwordx4 v[212:215], v15, s[8:11], s56 offen offset:1024 nt
  s_waitcnt vmcnt(11)
  buffer_load_dwordx4 v[216:219], v15, s[8:11], s56 offen offset:2048 nt
  s_waitcnt vmcnt(11)
  buffer_load_dwordx4 v[220:223], v15, s[8:11], s56 offen offset:3072 nt
  s_lshr_b32 s56, s96, 13
  s_add_u32 s96, s96, s97
  s_waitcnt vmcnt(11)
  buffer_load_dwordx4 v[224:227], v15, s[8:11], s56 offen offset:0 nt
  s_waitcnt vmcnt(11)
  buffer_load_dwordx4 v[228:231], v15, s[8:11], s56 offen offset:1024 nt
  s_waitcnt vmcnt(11)
  buffer_load_dwordx4 v[232:235], v15, s[8:11], s56 offen offset:2048 nt
  s_waitcnt vmcnt(11)
  buffer_load_dwordx4 v[236:239], v15, s[8:11], s56 offen offset:3072 nt
  s_lshr_b32 s56, s96, 13
  s_add_u32 s96, s96, s97
  s_waitcnt vmcnt(11)
  buffer_load_dwordx4 v[240:243], v15, s[8:11], s56 offen offset:0 nt
  s_waitcnt vmcnt(11)
  buffer_load_dwordx4 v[244:247], v15, s[8:11], s56 offen offset:1024 nt
  s_waitcnt vmcnt(11)
  buffer_load_dwordx4 v[248:251], v15, s[8:11], s56 offen offset:2048 nt
  s_waitcnt vmcnt(11)
  buffer_load_dwordx4 v[252:255], v15, s[8:11], s56 offen offset:3072 nt
L_vsd:
  s_barrier
  ds_read_b128 v[4:7], v13
  ds_read_b32 v8, v10 offset:4
  ds_read_b128 v[64:67], v20 offset:0
  ds_read_b128 v[68:71], v21 offset:0
  ds_read_b128 v[72:75], v22 offset:0
  ds_read_b128 v[76:79], v23 offset:0
  ds_read_b128 v[80:83], v20 offset:256
  ds_read_b128 v[84:87], v21 offset:256
  ds_read_b128 v[88:91], v22 offset:256
  ds_read_b128 v[92:95], v23 offset:256
  s_waitcnt lgkmcnt(0)
  ds_read_b128 v[96:99], v20 offset:512
  ds_read_b128 v[100:103], v21 offset:512
  ds_read_b128 v[104:107], v22 offset:512
  ds_read_b128 v[108:111], v23 offset:512
  ds_read_b128 v[112:115], v20 offset:768
  ds_read_b128 v[116:119], v21 offset:768
  ds_read_b128 v[120:123], v22 offset:768
  ds_read_b128 v[124:127], v23 offset:768
  v_readfirstlane_b32 s13, v8
  v_max3_f32 v8, v4, v5, v6
  v_max_f32 v8, v8, v7
  v_sub_f32 v4, v4, v8
  v_sub_f32 v5, v5, v8
  v_sub_f32 v6, v6, v8
  v_sub_f32 v7, v7, v8
  v_exp_f32 v4, v4
  v_exp_f32 v5, v5
  v_exp_f32 v6, v6
  v_exp_f32 v7, v7
  s_lshr_b32 s13, s13, 8
  s_waitcnt vmcnt(24)
  v_perm_b32 v32, v132, v128, s60
  v_perm_b32 v33, v140, v136, s60
  v_perm_b32 v34, v148, v144, s60
  v_perm_b32 v35, v156, v152, s60
  v_perm_b32 v36, v132, v128, s61
  v_perm_b32 v37, v140, v136, s61
  v_perm_b32 v38, v148, v144, s61
  v_perm_b32 v39, v156, v152, s61
  v_mfma_f32_16x16x32_bf16 v[24:27], v[32:35], v[64:67], 0
  v_perm_b32 v40, v133, v129, s60
  v_perm_b32 v41, v141, v137, s60
  v_perm_b32 v42, v149, v145, s60
  v_perm_b32 v43, v157, v153, s60
  v_mfma_f32_16x16x32_bf16 v[24:27], v[36:39], v[68:71], v[24:27]
  v_perm_b32 v44, v133, v129, s61
  v_perm_b32 v45, v141, v137, s61
  v_perm_b32 v46, v149, v145, s61
  v_perm_b32 v47, v157, v153, s61
  v_mfma_f32_16x16x32_bf16 v[24:27], v[40:43], v[72:75], v[24:27]
  v_perm_b32 v48, v134, v130, s60
  v_perm_b32 v49, v142, v138, s60
  v_perm_b32 v50, v150, v146, s60
  v_perm_b32 v51, v158, v154, s60
  v_mfma_f32_16x16x32_bf16 v[24:27], v[44:47], v[76:79], v[24:27]
  v_perm_b32 v52, v134, v130, s61
  v_perm_b32 v53, v142, v138, s61
  v_perm_b32 v54, v150, v146, s61
  v_perm_b32 v55, v158, v154, s61
  v_mfma_f32_16x16x32_bf16 v[28:31], v[48:51], v[64:67], 0
  v_perm_b32 v56, v135, v131, s60
  v_perm_b32 v57, v143, v139, s60
  v_perm_b32 v58, v151, v147, s60
  v_perm_b32 v59, v159, v155, s60
  v_mfma_f32_16x16x32_bf16 v[28:31], v[52:55], v[68:71], v[28:31]
  v_perm_b32 v60, v135, v131, s61
  v_perm_b32 v61, v143, v139, s61
  v_perm_b32 v62, v151, v147, s61
  v_perm_b32 v63, v159, v155, s61
  v_mfma_f32_16x16x32_bf16 v[28:31], v[56:59], v[72:75], v[28:31]
  s_nop 1
  v_mfma_f32_16x16x32_bf16 v[28:31], v[60:63], v[76:79], v[28:31]
  s_waitcnt vmcnt(16)
  v_perm_b32 v32, v164, v160, s60
  v_perm_b32 v33, v172, v168, s60
  v_perm_b32 v34, v180, v176, s60
  v_perm_b32 v35, v188, v184, s60
  v_perm_b32 v36, v164, v160, s61
  v_perm_b32 v37, v172, v168, s61
  v_perm_b32 v38, v180, v176, s61
  v_perm_b32 v39, v188, v184, s61
  v_mfma_f32_16x16x32_bf16 v[24:27], v[32:35], v[80:83], v[24:27]
  v_perm_b32 v40, v165, v161, s60
  v_perm_b32 v41, v173, v169, s60
  v_perm_b32 v42, v181, v177, s60
  v_perm_b32 v43, v189, v185, s60
  v_mfma_f32_16x16x32_bf16 v[24:27], v[36:39], v[84:87], v[24:27]
  v_perm_b32 v44, v165, v161, s61
  v_perm_b32 v45, v173, v169, s61
  v_perm_b32 v46, v181, v177, s61
  v_perm_b32 v47, v189, v185, s61
  v_mfma_f32_16x16x32_bf16 v[24:27], v[40:43], v[88:91], v[24:27]
  v_perm_b32 v48, v166, v162, s60
  v_perm_b32 v49, v174, v170, s60
  v_perm_b32 v50, v182, v178, s60
  v_perm_b32 v51, v190, v186, s60
  v_mfma_f32_16x16x32_bf16 v[24:27], v[44:47], v[92:95], v[24:27]
  v_perm_b32 v52, v166, v162, s61
  v_perm_b32 v53, v174, v170, s61
  v_perm_b32 v54, v182, v178, s61
  v_perm_b32 v55, v190, v186, s61
  v_mfma_f32_16x16x32_bf16 v[28:31], v[48:51], v[80:83], v[28:31]
  v_perm_b32 v56, v167, v163, s60
  v_perm_b32 v57, v175, v171, s60
  v_perm_b32 v58, v183, v179, s60
  v_perm_b32 v59, v191, v187, s60
  v_mfma_f32_16x16x32_bf16 v[28:31], v[52:55], v[84:87], v[28:31]
  v_perm_b32 v60, v167, v163, s61
  v_perm_b32 v61, v175, v171, s61
  v_perm_b32 v62, v183, v179, s61
  v_perm_b32 v63, v191, v187, s61
  v_mfma_f32_16x16x32_bf16 v[28:31], v[56:59], v[88:91], v[28:31]
  s_nop 1
  v_mfma_f32_16x16x32_bf16 v[28:31], v[60:63], v[92:95], v[28:31]
  s_waitcnt vmcnt(8) lgkmcnt(0)
  v_perm_b32 v32, v196, v192, s60
  v_perm_b32 v33, v204, v200, s60
  v_perm_b32 v34, v212, v208, s60
  v_perm_b32 v35, v220, v216, s60
  v_perm_b32 v36, v196, v192, s61
  v_perm_b32 v37, v204, v200, s61
  v_perm_b32 v38, v212, v208, s61
  v_perm_b32 v39, v220, v216, s61
  v_mfma_f32_16x16x32_bf16 v[24:27], v[32:35], v[96:99], v[24:27]
  v_perm_b32 v40, v197, v193, s60
  v_perm_b32 v41, v205, v201, s60
  v_perm_b32 v42, v213, v209, s60
  v_perm_b32 v43, v221, v217, s60
  v_mfma_f32_16x16x32_bf16 v[24:27], v[36:39], v[100:103], v[24:27]
  v_perm_b32 v44, v197, v193, s61
  v_perm_b32 v45, v205, v201, s61
  v_perm_b32 v46, v213, v209, s61
  v_perm_b32 v47, v221, v217, s61
  v_mfma_f32_16x16x32_bf16 v[24:27], v[40:43], v[104:107], v[24:27]
  v_perm_b32 v48, v198, v194, s60
  v_perm_b32 v49, v206, v202, s60
  v_perm_b32 v50, v214, v210, s60
  v_perm_b32 v51, v222, v218, s60
  v_mfma_f32_16x16x32_bf16 v[24:27], v[44:47], v[108:111], v[24:27]
  v_perm_b32 v52, v198, v194, s61
  v_perm_b32 v53, v206, v202, s61
  v_perm_b32 v54, v214, v210, s61
  v_perm_b32 v55, v222, v218, s61
  v_mfma_f32_16x16x32_bf16 v[28:31], v[48:51], v[96:99], v[28:31]
  v_perm_b32 v56, v199, v195, s60
  v_perm_b32 v57, v207, v203, s60
  v_perm_b32 v58, v215, v211, s60
  v_perm_b32 v59, v223, v219, s60
  v_mfma_f32_16x16x32_bf16 v[28:31], v[52:55], v[100:103], v[28:31]
  v_perm_b32 v60, v199, v195, s61
  v_perm_b32 v61, v207, v203, s61
  v_perm_b32 v62, v215, v211, s61
  v_perm_b32 v63, v223, v219, s61
  v_mfma_f32_16x16x32_bf16 v[28:31], v[56:59], v[104:107], v[28:31]
  s_nop 1
  v_mfma_f32_16x16x32_bf16 v[28:31], v[60:63], v[108:111], v[28:31]
  s_nop 4
  s_waitcnt vmcnt(6)
  v_perm_b32 v32, v228, v224, s60
  v_perm_b32 v36, v228, v224, s61
  v_perm_b32 v40, v229, v225, s60
  v_perm_b32 v44, v229, v225, s61
  v_perm_b32 v48, v230, v226, s60
  v_perm_b32 v52, v230, v226, s61
  v_perm_b32 v56, v231, v227, s60
  v_perm_b32 v60, v231, v227, s61
  s_waitcnt vmcnt(4)
  v_perm_b32 v33, v236, v232, s60
  v_perm_b32 v37, v236, v232, s61
  v_perm_b32 v41, v237, v233, s60
  v_perm_b32 v45, v237, v233, s61
  v_perm_b32 v49, v238, v234, s60
  v_perm_b32 v53, v238, v234, s61
  v_perm_b32 v57, v239, v235, s60
  v_perm_b32 v61, v239, v235, s61
  s_waitcnt vmcnt(2)
  v_perm_b32 v34, v244, v240, s60
  v_perm_b32 v38, v244, v240, s61
  v_perm_b32 v42, v245, v241, s60
  v_perm_b32 v46, v245, v241, s61
  v_perm_b32 v50, v246, v242, s60
  v_perm_b32 v54, v246, v242, s61
  v_perm_b32 v58, v247, v243, s60
  v_perm_b32 v62, v247, v243, s61
  s_waitcnt vmcnt(0)
  v_perm_b32 v35, v252, v248, s60
  v_perm_b32 v39, v252, v248, s61
  v_perm_b32 v43, v253, v249, s60
  v_perm_b32 v47, v253, v249, s61
  v_perm_b32 v51, v254, v250, s60
  v_perm_b32 v55, v254, v250, s61
  v_perm_b32 v59, v255, v251, s60
  v_perm_b32 v63, v255, v251, s61
  v_mfma_f32_16x16x32_bf16 v[24:27], v[32:35], v[112:115], v[24:27]
  v_mfma_f32_16x16x32_bf16 v[28:31], v[48:51], v[112:115], v[28:31]
  v_mfma_f32_16x16x32_bf16 v[24:27], v[36:39], v[116:119], v[24:27]
  v_mfma_f32_16x16x32_bf16 v[28:31], v[52:55], v[116:119], v[28:31]
  v_mfma_f32_16x16x32_bf16 v[24:27], v[40:43], v[120:123], v[24:27]
  v_mfma_f32_16x16x32_bf16 v[28:31], v[56:59], v[120:123], v[28:31]
  v_mfma_f32_16x16x32_bf16 v[24:27], v[44:47], v[124:127], v[24:27]
  v_mfma_f32_16x16x32_bf16 v[28:31], v[60:63], v[124:127], v[28:31]
  s_mov_b32 s59, 200000
  s_nop 5
  ds_write_b128 v19, v[24:27]
  ds_write_b128 v19, v[28:31] offset:1024
  s_mov_b64 exec, 1
  ds_add_u32 v2, v3
  s_mov_b64 exec, -1
L_ospin:
  ds_read_b32 v3, v2
  ds_read_b128 v[64:67], v12 offset:0
  ds_read_b128 v[68:71], v12 offset:2048
  ds_read_b128 v[72:75], v12 offset:4096
  ds_read_b128 v[76:79], v12 offset:6144
  s_waitcnt lgkmcnt(4)
  v_readfirstlane_b32 s56, v3
  s_cmp_eq_u32 s56, 4
  s_cbranch_scc1 L_oall
  s_sub_u32 s59, s59, 1
  s_cbranch_scc0 L_ospin
L_oall:
  s_waitcnt lgkmcnt(3)
  v_pk_mul_f32 v[24:25], v[64:65], v[4:5] op_sel_hi:[1,0]
  v_pk_mul_f32 v[26:27], v[66:67], v[4:5] op_sel_hi:[1,0]
  s_waitcnt lgkmcnt(2)
  v_pk_fma_f32 v[24:25], v[68:69], v[4:5], v[24:25] op_sel:[0,1,0] op_sel_hi:[1,1,1]
  v_pk_fma_f32 v[26:27], v[70:71], v[4:5], v[26:27] op_sel:[0,1,0] op_sel_hi:[1,1,1]
  s_waitcnt lgkmcnt(1)
  v_pk_fma_f32 v[24:25], v[72:73], v[6:7], v[24:25] op_sel:[0,0,0] op_sel_hi:[1,0,1]
  v_pk_fma_f32 v[26:27], v[74:75], v[6:7], v[26:27] op_sel:[0,0,0] op_sel_hi:[1,0,1]
  s_waitcnt lgkmcnt(0)
  v_pk_fma_f32 v[24:25], v[76:77], v[6:7], v[24:25] op_sel:[0,1,0] op_sel_hi:[1,1,1]
  v_pk_fma_f32 v[26:27], v[78:79], v[6:7], v[26:27] op_sel:[0,1,0] op_sel_hi:[1,1,1]
  v_cvt_pk_bf16_f32 v8, v24, v25
  v_cvt_pk_bf16_f32 v10, v26, v27
  s_mov_b32 exec_hi, 0
  s_cmp_eq_u32 s13, 0
  s_cbranch_scc1 L_tl1
  buffer_store_dwordx4 v[8:11], v14, s[20:23], s57 offen sc1
  s_branch L_td1
L_tl1:
  buffer_store_dwordx4 v[8:11], v14, s[20:23], s57 offen
L_td1:
  s_endpgm
L_end:
  s_endpgm
L_code_end:
.section .rodata,"a"
.p2align 6
.amdhsa_kernel gated_mix__sliding_block_cached__sliding_block_cached__decode_kernel
  .amdhsa_next_free_vgpr 256
  .amdhsa_next_free_sgpr 102
  .amdhsa_accum_offset 256
  .amdhsa_group_segment_fixed_size 0
  .amdhsa_kernarg_size 112
  .amdhsa_user_sgpr_count 2
  .amdhsa_user_sgpr_kernarg_segment_ptr 1
  .amdhsa_system_sgpr_workgroup_id_x 1
.end_amdhsa_kernel
```
